```python
import torch

def _softmax(x, axis=-1):
    return torch.softmax(x, dim=axis)
def _gelu(x):
    return torch.nn.functional.gelu(x, approximate="tanh")
def _silu(x):
    return torch.nn.functional.silu(x)
def _sigmoid(x):
    return torch.sigmoid(x)
def _layernorm(x, axis=-1, eps=1e-5):
    m = x.mean(dim=axis, keepdim=True)
    v = x.var(dim=axis, keepdim=True, unbiased=False)
    return (x - m) / torch.sqrt(v + eps)
def _scatter_add(tgt, idx, src, axis=0):
    return tgt.clone().index_add_(axis, idx, src)
def _segment_sum(src, seg, n):
    out = torch.zeros((n,) + src.shape[1:], dtype=src.dtype)
    return out.index_add_(0, seg, src)
def _pad(x, pw):
    flat = tuple(v for pair in reversed(pw) for v in pair)
    return torch.nn.functional.pad(x, flat)

kernel_name = 'standalone__geglu_ffn__decode'

def setup_inputs():

    _w = (lambda a: (lambda t: t.to(torch.bfloat16) if t.is_floating_point() else t)(torch.as_tensor(a)))
    B, S, D, F = 4, 1, 1024, 3584
    return {
        "x": _w((lambda *s: torch.randn(*s, dtype=torch.bfloat16) * 0.05)(B, S, D)),
        "w_gate": _w((lambda *s: torch.randn(*s, dtype=torch.bfloat16) * 0.05)(D, F)),
        "w_up": _w((lambda *s: torch.randn(*s, dtype=torch.bfloat16) * 0.05)(D, F)),
        "w_down": _w((lambda *s: torch.randn(*s, dtype=torch.bfloat16) * 0.05)(F, D)),
    }

def reference(x, w_gate, w_up, w_down):
    return (_gelu(x @ w_gate) * (x @ w_up)) @ w_down
```

```asm
; @launch grid=(256,1,1) block=(384,1,1) lds=10768
.amdgcn_target "amdgcn-amd-amdhsa--gfx950"
.text
.globl standalone__geglu_ffn__decode_kernel
.p2align 12
.type standalone__geglu_ffn__decode_kernel,@function
standalone__geglu_ffn__decode_kernel:
    s_load_dwordx8 s[4:11], s[0:1], 0
    s_load_dwordx4 s[12:15], s[0:1], 32
    s_load_dwordx2 s[16:17], s[0:1], 48
    v_readfirstlane_b32 s20, v0
    s_cmp_ge_u32 s2, 256
    s_cbranch_scc1 L_end
    s_cmp_lt_u32 s20, 256
    s_cbranch_scc1 L_main
    s_cmp_ge_u32 s20, 320
    s_cbranch_scc1 L_w5
    s_getpc_b64 s[24:25]
    v_lshlrev_b32 v1, 7, v0
    s_sub_u32 s24, s24, 32768
    s_subb_u32 s25, s25, 0
    s_mov_b32 exec_hi, 255
    global_load_dword v3, v1, s[24:25]
    s_mov_b64 exec, 0
    s_branch L_pad0
L_w5:
    s_mov_b64 exec, 0
    s_branch L_padM
L_main:
    s_lshr_b32 s24, s2, 3
    s_and_b32 s66, s2, 7
    s_mul_i32 s19, s24, 37
    s_lshr_b32 s19, s19, 8
    s_mul_i32 s25, s19, 7
    s_sub_u32 s67, s24, s25
    s_add_u32 s25, s66, 3
    s_and_b32 s25, s25, 7
    s_cmp_eq_u32 s25, 7
    s_cselect_b32 s25, 0, s25
    s_cmp_eq_u32 s67, s25
    s_cselect_b32 s36, 1, 0
    s_cmp_eq_u32 s19, 4
    s_cselect_b32 s36, 2, s36
    s_cselect_b32 s19, s67, s19
    s_cselect_b32 s67, s25, s67
    s_cselect_b32 s37, 128, 0
    s_mul_i32 s18, s66, 7
    s_add_u32 s18, s18, s67
    s_lshl_b32 s25, s19, 8
    s_add_u32 s24, s37, s25
    s_min_u32 s25, s36, 1
    v_and_b32 v13, 0xf0, v0
    v_lshrrev_b32 v13, s25, v13
    v_add_u32 v13, s24, v13
    v_and_b32 v14, 7, v0
    v_mul_u32_u24 v6, 7168, v13
    v_lshl_add_u32 v6, v14, 4, v6
    s_lshl_b32 s25, s18, 7
    s_add_u32 s25, s25, 3584
    v_add_u32 v6, s25, v6
    v_mov_b32 v7, 0
    v_bfe_u32 v14, v0, 2, 2
    v_lshlrev_b32 v2, 11, v14
    v_lshl_add_u32 v2, v13, 1, v2
    s_mov_b32 s26, 0xff00ff00
    s_mov_b32 s27, 0xff00ff00
    s_mov_b32 s22, 14336
    s_mov_b32 s23, 0
    s_cmp_lg_u32 s36, 0
    s_waitcnt lgkmcnt(0)
    v_lshl_add_u64 v[8:9], v[6:7], 0, s[6:7]
    s_mov_b64 exec, s[26:27]
    v_lshl_add_u64 v[8:9], v[6:7], 0, s[8:9]
    s_mov_b64 exec, -1
    s_cbranch_scc1 L_halfld
    global_load_dwordx4 v[72:75], v[8:9], off offset:-3584
    global_load_dwordx4 v[76:79], v[8:9], off offset:3584
    v_lshl_add_u64 v[8:9], v[8:9], 0, s[22:23]
    global_load_dwordx4 v[24:27], v2, s[4:5]
    v_add_u32 v2, 16, v2
    global_load_dwordx4 v[80:83], v[8:9], off offset:-3584
    global_load_dwordx4 v[84:87], v[8:9], off offset:3584
    v_lshl_add_u64 v[8:9], v[8:9], 0, s[22:23]
    global_load_dwordx4 v[88:91], v[8:9], off offset:-3584
    global_load_dwordx4 v[92:95], v[8:9], off offset:3584
    v_lshl_add_u64 v[8:9], v[8:9], 0, s[22:23]
    global_load_dwordx4 v[96:99], v[8:9], off offset:-3584
    global_load_dwordx4 v[100:103], v[8:9], off offset:3584
    v_lshl_add_u64 v[8:9], v[8:9], 0, s[22:23]
L_halfld:
    global_load_dwordx4 v[28:31], v2, s[4:5]
    global_load_dwordx4 v[104:107], v[8:9], off offset:-3584
    global_load_dwordx4 v[108:111], v[8:9], off offset:3584
    v_lshl_add_u64 v[8:9], v[8:9], 0, s[22:23]
    global_load_dwordx4 v[112:115], v[8:9], off offset:-3584
    global_load_dwordx4 v[116:119], v[8:9], off offset:3584
    v_lshl_add_u64 v[8:9], v[8:9], 0, s[22:23]
    global_load_dwordx4 v[120:123], v[8:9], off offset:-3584
    global_load_dwordx4 v[124:127], v[8:9], off offset:3584
    v_lshl_add_u64 v[8:9], v[8:9], 0, s[22:23]
    global_load_dwordx4 v[128:131], v[8:9], off offset:-3584
    global_load_dwordx4 v[132:135], v[8:9], off offset:3584
    s_load_dword s21, s[16:17], 0
L_pad0:
    s_cbranch_execz L_pad1
    s_mov_b32 s33, 0x1000000
    s_lshr_b32 s20, s20, 6
    v_and_b32 v1, 63, v0
    v_lshrrev_b32 v12, 3, v1
    v_lshlrev_b32 v3, 14, v12
    v_and_b32 v15, 7, v0
    v_lshl_add_u32 v3, v15, 4, v3
    s_lshl_b32 s24, s20, 7
    v_add_u32 v3, s24, v3
    s_lshl_b32 s24, s18, 17
    s_lshl_b32 s25, s19, 9
    s_add_u32 s24, s24, s25
    s_add_u32 s24, s24, 4096
    v_add_u32 v3, s24, v3
    v_add_u32 v4, 8192, v3
    s_cmp_eq_u32 s36, 2
    s_cselect_b64 s[34:35], 1, -1
    v_and_b32 v12, 3, v0
    v_lshlrev_b32 v13, 4, v12
    s_mov_b32 s22, 0xffff
    v_lshlrev_b64 v[10:11], v13, s[22:23]
    v_mov_b32 v5, 0xff
    s_mul_i32 s24, s20, 2560
    v_lshlrev_b32 v13, 4, v1
    v_lshrrev_b32 v14, 4, v1
    v_lshl_add_u32 v16, v14, 5, v13
    v_add_u32 v16, s24, v16
    v_and_b32 v15, 1, v0
    v_lshl_add_u32 v15, v14, 1, v15
    v_lshlrev_b32 v21, 6, v15
    v_bfe_u32 v15, v0, 2, 2
    v_lshl_add_u32 v21, v15, 4, v21
    v_mov_b32 v22, 10752
    s_lshl_b32 s24, s19, 5
    s_lshl1_add_u32 s24, s20, s24
    s_mul_i32 s24, s24, 7168
    s_lshl_b32 s25, s18, 7
    s_add_u32 s24, s24, s25
    s_add_u32 s24, s24, 2293760
    v_bfe_u32 v15, v0, 2, 1
    v_lshl_add_u32 v14, v14, 3, v15
    v_mul_u32_u24 v23, 7168, v14
    v_and_b32 v15, 3, v0
    v_lshl_add_u32 v23, v15, 5, v23
L_pad1:
    s_cbranch_execz L_pad2
    v_bfe_u32 v15, v0, 3, 1
    v_lshl_add_u32 v23, v15, 4, v23
    v_add_u32 v23, s24, v23
    s_lshl_b32 s24, s66, 5
    s_lshr_b32 s25, s2, 3
    s_add_u32 s24, s24, s25
    s_lshl_b32 s24, s24, 7
    s_lshl2_add_u32 s24, s20, s24
    s_add_u32 s24, s24, 589824
    v_mov_b32 v17, s24
    s_mov_b32 s68, 0x05040100
    s_mov_b32 s69, 0x07060302
    v_mov_b32 v64, 0
    v_mov_b32 v65, 0
    v_mov_b32 v66, 0
    v_mov_b32 v67, 0
    v_mov_b32 v68, 0
    v_mov_b32 v69, 0
    v_mov_b32 v70, 0
    v_mov_b32 v71, 0
    s_mov_b32 s24, 0x01000100
    s_mov_b32 s25, 0x03020302
    s_cmp_lg_u32 s36, 0
    s_cbranch_scc1 L_half2
    s_waitcnt vmcnt(15)
    v_perm_b32 v12, v24, v24, s24
    v_and_b32 v32, v12, v10
    v_and_b32 v33, v12, v11
    v_perm_b32 v12, v24, v24, s25
    v_and_b32 v34, v12, v10
    v_and_b32 v35, v12, v11
    v_perm_b32 v12, v25, v25, s24
    v_and_b32 v36, v12, v10
    v_and_b32 v37, v12, v11
    v_perm_b32 v12, v25, v25, s25
    v_and_b32 v38, v12, v10
    v_and_b32 v39, v12, v11
    v_perm_b32 v12, v26, v26, s24
    v_and_b32 v40, v12, v10
    v_and_b32 v41, v12, v11
    v_perm_b32 v12, v26, v26, s25
    v_and_b32 v42, v12, v10
    v_and_b32 v43, v12, v11
    v_perm_b32 v12, v27, v27, s24
    v_and_b32 v44, v12, v10
    v_and_b32 v45, v12, v11
    v_perm_b32 v12, v27, v27, s25
    v_and_b32 v46, v12, v10
L_pad2:
    s_cbranch_execz L_pad3
    v_and_b32 v47, v12, v11
    v_mfma_f32_16x16x16_bf16 v[64:67], v[32:33], v[72:73], v[64:67]
    v_mfma_f32_16x16x16_bf16 v[68:71], v[32:33], v[74:75], v[68:71]
    v_mfma_f32_16x16x16_bf16 v[64:67], v[34:35], v[76:77], v[64:67]
    v_mfma_f32_16x16x16_bf16 v[68:71], v[34:35], v[78:79], v[68:71]
    s_waitcnt vmcnt(14)
    v_mfma_f32_16x16x16_bf16 v[64:67], v[36:37], v[80:81], v[64:67]
    v_mfma_f32_16x16x16_bf16 v[68:71], v[36:37], v[82:83], v[68:71]
    s_waitcnt vmcnt(13)
    v_mfma_f32_16x16x16_bf16 v[64:67], v[38:39], v[84:85], v[64:67]
    v_mfma_f32_16x16x16_bf16 v[68:71], v[38:39], v[86:87], v[68:71]
    s_waitcnt vmcnt(12)
    v_mfma_f32_16x16x16_bf16 v[64:67], v[40:41], v[88:89], v[64:67]
    v_mfma_f32_16x16x16_bf16 v[68:71], v[40:41], v[90:91], v[68:71]
    s_waitcnt vmcnt(11)
    v_mfma_f32_16x16x16_bf16 v[64:67], v[42:43], v[92:93], v[64:67]
    v_mfma_f32_16x16x16_bf16 v[68:71], v[42:43], v[94:95], v[68:71]
    s_waitcnt vmcnt(10)
    v_mfma_f32_16x16x16_bf16 v[64:67], v[44:45], v[96:97], v[64:67]
    v_mfma_f32_16x16x16_bf16 v[68:71], v[44:45], v[98:99], v[68:71]
    s_waitcnt vmcnt(9)
    v_mfma_f32_16x16x16_bf16 v[64:67], v[46:47], v[100:101], v[64:67]
    v_mfma_f32_16x16x16_bf16 v[68:71], v[46:47], v[102:103], v[68:71]
L_half2:
    s_waitcnt vmcnt(8)
    v_perm_b32 v12, v28, v28, s24
    v_and_b32 v48, v12, v10
    v_and_b32 v49, v12, v11
    v_perm_b32 v12, v28, v28, s25
    v_and_b32 v50, v12, v10
    v_and_b32 v51, v12, v11
    v_perm_b32 v12, v29, v29, s24
    v_and_b32 v52, v12, v10
    v_and_b32 v53, v12, v11
    v_perm_b32 v12, v29, v29, s25
    v_and_b32 v54, v12, v10
    v_and_b32 v55, v12, v11
    v_perm_b32 v12, v30, v30, s24
    v_and_b32 v56, v12, v10
    v_and_b32 v57, v12, v11
    v_perm_b32 v12, v30, v30, s25
    v_and_b32 v58, v12, v10
L_pad3:
    s_cbranch_execz L_pad4
    v_and_b32 v59, v12, v11
    v_perm_b32 v12, v31, v31, s24
    v_and_b32 v60, v12, v10
    v_and_b32 v61, v12, v11
    v_perm_b32 v12, v31, v31, s25
    v_and_b32 v62, v12, v10
    v_and_b32 v63, v12, v11
    s_waitcnt lgkmcnt(0)
    s_add_u32 s21, s21, 0x9f3b79b1
    s_bfe_u32 s28, s21, 0x80000
    s_bfe_u32 s29, s21, 0x80008
    s_bfe_u32 s30, s21, 0x80010
    s_bfe_u32 s31, s21, 0x80018
    v_mov_b32 v18, s21
    s_waitcnt vmcnt(7)
    s_mov_b64 exec, s[34:35]
    global_load_dwordx4 v[136:139], v3, s[10:11] offset:-4096
    s_mov_b64 exec, -1
    v_mfma_f32_16x16x16_bf16 v[64:67], v[48:49], v[104:105], v[64:67]
    v_mfma_f32_16x16x16_bf16 v[68:71], v[48:49], v[106:107], v[68:71]
    s_waitcnt vmcnt(7)
    s_mov_b64 exec, s[34:35]
    global_load_dwordx4 v[140:143], v3, s[10:11] offset:-2048
    s_mov_b64 exec, -1
    v_mfma_f32_16x16x16_bf16 v[64:67], v[50:51], v[108:109], v[64:67]
    v_mfma_f32_16x16x16_bf16 v[68:71], v[50:51], v[110:111], v[68:71]
    s_waitcnt vmcnt(7)
    s_mov_b64 exec, s[34:35]
    global_load_dwordx4 v[144:147], v3, s[10:11] offset:0
    s_mov_b64 exec, -1
    v_mfma_f32_16x16x16_bf16 v[64:67], v[52:53], v[112:113], v[64:67]
    v_mfma_f32_16x16x16_bf16 v[68:71], v[52:53], v[114:115], v[68:71]
    s_waitcnt vmcnt(7)
    s_mov_b64 exec, s[34:35]
    global_load_dwordx4 v[148:151], v3, s[10:11] offset:2048
    s_mov_b64 exec, -1
    v_mfma_f32_16x16x16_bf16 v[64:67], v[54:55], v[116:117], v[64:67]
    v_mfma_f32_16x16x16_bf16 v[68:71], v[54:55], v[118:119], v[68:71]
    s_waitcnt vmcnt(7)
    v_mfma_f32_16x16x16_bf16 v[64:67], v[56:57], v[120:121], v[64:67]
    v_mfma_f32_16x16x16_bf16 v[68:71], v[56:57], v[122:123], v[68:71]
    s_waitcnt vmcnt(6)
L_pad4:
    s_cbranch_execz L_pad5
    v_mfma_f32_16x16x16_bf16 v[64:67], v[58:59], v[124:125], v[64:67]
    v_mfma_f32_16x16x16_bf16 v[68:71], v[58:59], v[126:127], v[68:71]
    s_waitcnt vmcnt(5)
    v_mfma_f32_16x16x16_bf16 v[64:67], v[60:61], v[128:129], v[64:67]
    v_mfma_f32_16x16x16_bf16 v[68:71], v[60:61], v[130:131], v[68:71]
    s_waitcnt vmcnt(4)
    v_mfma_f32_16x16x16_bf16 v[64:67], v[62:63], v[132:133], v[64:67]
    v_mfma_f32_16x16x16_bf16 v[68:71], v[62:63], v[134:135], v[68:71]
    s_nop 6
    ds_write_b128 v16, v[64:67]
    ds_write_b128 v16, v[68:71] offset:1168
    s_cmp_eq_u32 s36, 2
    s_waitcnt lgkmcnt(0)
    s_barrier
    s_cbranch_scc1 L_end
    s_barrier
    global_load_dwordx4 v[152:155], v4, s[10:11] offset:-4096
    global_load_dwordx4 v[156:159], v4, s[10:11] offset:-2048
    s_barrier
    global_load_dwordx4 v[160:163], v4, s[10:11] offset:0
    global_load_dwordx4 v[164:167], v4, s[10:11] offset:2048
    s_waitcnt vmcnt(6)
    v_perm_b32 v32, v140, v136, s68
    v_perm_b32 v36, v140, v136, s69
    v_perm_b32 v40, v141, v137, s68
    v_perm_b32 v44, v141, v137, s69
    v_perm_b32 v48, v142, v138, s68
    v_perm_b32 v52, v142, v138, s69
    v_perm_b32 v56, v143, v139, s68
    v_perm_b32 v60, v143, v139, s69
    s_waitcnt vmcnt(4)
    v_perm_b32 v33, v148, v144, s68
    v_perm_b32 v37, v148, v144, s69
    v_perm_b32 v41, v149, v145, s68
    v_perm_b32 v45, v149, v145, s69
    v_perm_b32 v49, v150, v146, s68
    v_perm_b32 v53, v150, v146, s69
L_pad5:
    s_cbranch_execz L_pad6
    v_perm_b32 v57, v151, v147, s68
    v_perm_b32 v61, v151, v147, s69
    s_waitcnt vmcnt(2)
    v_perm_b32 v34, v156, v152, s68
    v_perm_b32 v38, v156, v152, s69
    v_perm_b32 v42, v157, v153, s68
    v_perm_b32 v46, v157, v153, s69
    v_perm_b32 v50, v158, v154, s68
    v_perm_b32 v54, v158, v154, s69
    v_perm_b32 v58, v159, v155, s68
    v_perm_b32 v62, v159, v155, s69
    s_waitcnt vmcnt(0)
    ds_read_b64 v[76:77], v22
    ds_read_b128 v[72:75], v21 offset:10240
    v_perm_b32 v35, v164, v160, s68
    v_perm_b32 v39, v164, v160, s69
    v_perm_b32 v43, v165, v161, s68
    v_perm_b32 v47, v165, v161, s69
    v_perm_b32 v51, v166, v162, s68
    v_perm_b32 v55, v166, v162, s69
    v_perm_b32 v59, v167, v163, s68
    v_perm_b32 v63, v167, v163, s69
L_hw2:
    s_waitcnt lgkmcnt(0)
    v_and_b32 v76, v76, v77
    v_cmp_ne_u32 vcc, v76, v5
    s_cbranch_vccnz L_hw
    s_mov_b64 exec, 1
    global_store_dword v17, v18, s[16:17]
    s_mov_b64 exec, -1
    v_mfma_f32_16x16x32_bf16 v[136:139], v[72:75], v[32:35], 0
    v_mfma_f32_16x16x32_bf16 v[152:155], v[72:75], v[48:51], 0
    v_mfma_f32_16x16x32_bf16 v[140:143], v[72:75], v[36:39], 0
    v_mfma_f32_16x16x32_bf16 v[156:159], v[72:75], v[52:55], 0
    v_mfma_f32_16x16x32_bf16 v[144:147], v[72:75], v[40:43], 0
    v_mfma_f32_16x16x32_bf16 v[160:163], v[72:75], v[56:59], 0
L_pad6:
    s_cbranch_execz L_pad7
    v_mfma_f32_16x16x32_bf16 v[148:151], v[72:75], v[44:47], 0
    v_mfma_f32_16x16x32_bf16 v[164:167], v[72:75], v[60:63], 0
    s_nop 1
    v_add_f32_dpp v80, v137, v136 row_ror:8 row_mask:0xf bank_mask:0x3
    v_add_f32_dpp v80, v152, v153 row_ror:8 row_mask:0xf bank_mask:0xc
    v_add_f32_dpp v81, v141, v140 row_ror:8 row_mask:0xf bank_mask:0x3
    v_add_f32_dpp v81, v156, v157 row_ror:8 row_mask:0xf bank_mask:0xc
    v_add_f32_dpp v82, v145, v144 row_ror:8 row_mask:0xf bank_mask:0x3
    v_add_f32_dpp v82, v160, v161 row_ror:8 row_mask:0xf bank_mask:0xc
    v_add_f32_dpp v83, v149, v148 row_ror:8 row_mask:0xf bank_mask:0x3
    v_add_f32_dpp v83, v164, v165 row_ror:8 row_mask:0xf bank_mask:0xc
    v_bfi_b32 v80, v5, s28, v80
    v_bfi_b32 v81, v5, s29, v81
    v_bfi_b32 v82, v5, s30, v82
    v_bfi_b32 v83, v5, s31, v83
    global_store_dwordx4 v23, v[80:83], s[16:17] sc1
    s_endpgm
L_hw:
    ds_read_b64 v[76:77], v22
    ds_read_b128 v[72:75], v21 offset:10240
    s_sub_u32 s33, s33, 1
    s_cbranch_scc0 L_hw2
    s_endpgm
L_pad7:
    s_branch L_padE
L_padM:
    s_cbranch_execz L_pad8
L_side1:
    ds_read2st64_b64 v[36:39], v8 offset0:0 offset1:5
    ds_read2st64_b64 v[44:47], v9 offset0:0 offset1:5
    ds_read2st64_b64 v[40:43], v8 offset0:10 offset1:15
    ds_read2st64_b64 v[48:51], v9 offset0:10 offset1:15
    s_cmp_lg_u32 s36, 0
    s_waitcnt lgkmcnt(2)
    v_pk_add_f32 v[36:37], v[36:37], v[38:39]
    v_pk_add_f32 v[38:39], v[44:45], v[46:47]
    s_waitcnt lgkmcnt(0)
    v_pk_add_f32 v[40:41], v[40:41], v[42:43]
    v_pk_add_f32 v[42:43], v[48:49], v[50:51]
    v_pk_add_f32 v[28:29], v[36:37], v[40:41]
    v_pk_add_f32 v[30:31], v[38:39], v[42:43]
    v_bfi_b32 v32, v17, s28, v28
    v_bfi_b32 v33, v17, s29, v29
    v_bfi_b32 v34, v17, s30, v30
    v_bfi_b32 v35, v17, s84, v31
    global_store_dwordx4 v10, v[32:35], s[16:17]
    s_barrier
    s_cbranch_scc1 L_special
    s_sleep 4
    global_load_dwordx4 v[52:55], v11, s[86:87] sc1
    global_load_dwordx4 v[56:59], v12, s[86:87] sc1
    global_load_dwordx4 v[60:63], v13, s[86:87] sc1
    s_barrier
L_chk1:
    s_waitcnt vmcnt(0)
    v_xor_b32 v52, s28, v52
    v_xor_b32 v53, s29, v53
    v_xor_b32 v54, s30, v54
    v_xor_b32 v55, s85, v55
    v_xor_b32 v56, s28, v56
    v_xor_b32 v57, s29, v57
    v_xor_b32 v58, s30, v58
    v_xor_b32 v59, s85, v59
    v_xor_b32 v60, s28, v60
    v_xor_b32 v61, s29, v61
    v_xor_b32 v62, s30, v62
    v_xor_b32 v63, s85, v63
    v_or3_b32 v24, v52, v53, v54
    v_or3_b32 v25, v55, v56, v57
    v_or3_b32 v24, v24, v58, v59
L_pad8:
    s_cbranch_execz L_pad9
    v_or3_b32 v25, v25, v60, v61
    v_or3_b32 v24, v24, v62, v63
    v_or_b32 v25, v25, v24
    v_cmp_ne_u32_sdwa vcc, v25, v7 src0_sel:BYTE_0 src1_sel:DWORD
    v_pk_add_f32 v[52:53], v[52:53], v[56:57]
    v_pk_add_f32 v[60:61], v[60:61], v[28:29]
    v_pk_add_f32 v[54:55], v[54:55], v[58:59]
    v_pk_add_f32 v[62:63], v[62:63], v[30:31]
    s_cbranch_vccnz L_repoll1
    v_pk_add_f32 v[52:53], v[52:53], v[60:61]
    v_pk_add_f32 v[54:55], v[54:55], v[62:63]
    v_mul_f32 v56, v52, v52
    v_mul_f32 v57, v53, v53
    v_fma_f32 v56, v56, s32, v18
    v_fma_f32 v57, v57, s32, v18
    v_mul_f32 v56, v56, v52
    v_mul_f32 v57, v57, v53
    v_exp_f32 v56, v56
    v_exp_f32 v57, v57
    v_mul_f32 v54, v54, v52
    v_mul_f32 v55, v55, v53
    v_add_f32 v56, 1.0, v56
    v_add_f32 v57, 1.0, v57
    v_rcp_f32 v56, v56
    v_rcp_f32 v57, v57
    s_nop 0
    v_mul_f32 v54, v54, v56
    v_mul_f32 v55, v55, v57
    v_cvt_pk_bf16_f32 v56, v54, v55
    ds_write_b32 v15, v56
    ds_write_b32 v16, v17
L_red:
    s_mov_b64 exec, 0xfffffff
L_gate:
    global_load_dwordx4 v[52:55], v21, s[16:17] sc1
    s_sub_u32 s34, s34, 1
    s_cbranch_scc1 L_gate_done
    s_waitcnt vmcnt(0)
    v_xor_b32 v52, v52, v22
    v_xor_b32 v53, v53, v22
    v_xor_b32 v54, v54, v22
    v_xor_b32 v55, v55, v22
    v_or3_b32 v52, v52, v53, v54
    v_or_b32 v52, v52, v55
    v_cmp_ne_u32 vcc, 0, v52
    s_cbranch_vccnz L_gate
L_gate_done:
L_poll2:
    s_or_b64 exec, s[70:71], 1
    global_load_dwordx4 v[52:55], v19, s[16:17] offset:0 sc1
    s_or_b64 exec, s[72:73], 1
    global_load_dwordx4 v[56:59], v19, s[16:17] offset:3584 sc1
    s_mov_b64 exec, s[70:71]
    s_cbranch_execz L_rs0
L_pad9:
    s_cbranch_execz L_pad10
    s_waitcnt vmcnt(1)
    v_xor_b32 v52, s28, v52
    v_xor_b32 v53, s29, v53
    v_xor_b32 v54, s30, v54
    v_xor_b32 v55, s31, v55
    v_or3_b32 v24, v52, v53, v54
    v_or_b32 v24, v24, v55
    v_cmp_eq_u32_sdwa vcc, v24, v7 src0_sel:BYTE_0 src1_sel:DWORD
    s_andn2_b64 s[70:71], s[70:71], vcc
    s_mov_b64 exec, vcc
    v_pk_add_f32 v[80:81], v[80:81], v[52:53]
    v_pk_add_f32 v[82:83], v[82:83], v[54:55]
L_rs0:
    s_mov_b64 exec, s[72:73]
    s_cbranch_execz L_rs1
    s_waitcnt vmcnt(0)
    v_xor_b32 v56, s28, v56
    v_xor_b32 v57, s29, v57
    v_xor_b32 v58, s30, v58
    v_xor_b32 v59, s31, v59
    v_or3_b32 v24, v56, v57, v58
    v_or_b32 v24, v24, v59
    v_cmp_eq_u32_sdwa vcc, v24, v7 src0_sel:BYTE_0 src1_sel:DWORD
    s_andn2_b64 s[72:73], s[72:73], vcc
    s_mov_b64 exec, vcc
    v_pk_add_f32 v[80:81], v[80:81], v[56:57]
    v_pk_add_f32 v[82:83], v[82:83], v[58:59]
L_rs1:
    s_or_b64 s[24:25], s[70:71], s[72:73]
    s_cbranch_scc1 L_repoll2
L_p2done:
    s_mov_b64 exec, -1
    s_nop 0
    v_permlane32_swap_b32 v80, v82
    v_permlane32_swap_b32 v81, v83
    s_nop 0
    v_pk_add_f32 v[80:81], v[80:81], v[82:83]
    s_nop 1
    v_permlane16_swap_b32 v80, v81
    s_nop 0
    v_add_f32 v80, v80, v81
    s_nop 1
    v_add_f32_dpp v80, v80, v80 row_ror:8 row_mask:0xf bank_mask:0xf
    s_nop 1
    v_add_f32_dpp v80, v80, v80 row_ror:4 row_mask:0xf bank_mask:0xf
    s_nop 1
    v_add_f32_dpp v80, v80, v80 quad_perm:[2,3,0,1] row_mask:0xf bank_mask:0xf
    s_mov_b64 exec, s[26:27]
    v_cvt_pk_bf16_f32 v80, v80, v80
    global_store_short v20, v80, s[12:13] nt
    s_cmp_lg_u32 s35, 0
    s_cbranch_scc1 L_end
L_pad10:
    s_cbranch_execz L_pad11
    s_mov_b64 exec, 1
    global_store_dword v7, v22, s[16:17] sc1
    s_endpgm
L_repoll2:
    s_sub_u32 s33, s33, 1
    s_cbranch_scc0 L_poll2
    s_endpgm
L_repoll1:
    s_sub_u32 s33, s33, 1
    s_cbranch_scc1 L_end
    s_cmp_gt_u32 s33, 1048567
    s_cbranch_scc1 L_poll1
    s_cmp_lg_u32 s33, 1048567
    s_cbranch_scc1 L_poll1_x
    v_bfi_b32 v35, v17, s31, v35
    global_store_dwordx4 v10, v[32:35], s[88:89] sc1
L_poll1_x:
    s_bitcmp0_b32 s33, 0
    s_cselect_b64 s[86:87], s[16:17], s[88:89]
    s_cselect_b32 s85, s84, s31
L_poll1:
    global_load_dwordx4 v[52:55], v11, s[86:87] sc1
    global_load_dwordx4 v[56:59], v12, s[86:87] sc1
    global_load_dwordx4 v[60:63], v13, s[86:87] sc1
    s_branch L_chk1
L_special:
    s_cmp_eq_u32 s36, 1
    s_cbranch_scc1 L_pollh0
    s_nop 1
    v_bfi_b32 v35, v17, s31, v35
    global_store_dwordx4 v10, v[32:35], s[88:89] sc1
    s_branch L_red
L_pollh0:
    s_sleep 4
    global_load_dwordx4 v[64:67], v14, s[86:87] offset:-4096 sc1
    global_load_dwordx4 v[68:71], v14, s[86:87] offset:-2048 sc1
    global_load_dwordx4 v[72:75], v14, s[86:87] offset:0 sc1
    global_load_dwordx4 v[76:79], v14, s[86:87] offset:2048 sc1
    global_load_dwordx4 v[52:55], v11, s[86:87] sc1
    global_load_dwordx4 v[56:59], v12, s[86:87] sc1
    global_load_dwordx4 v[60:63], v13, s[86:87] sc1
    s_barrier
L_chkh:
    s_waitcnt vmcnt(3)
    v_xor_b32 v64, s28, v64
    v_xor_b32 v65, s29, v65
    v_xor_b32 v66, s30, v66
    v_xor_b32 v67, s85, v67
    v_xor_b32 v68, s28, v68
    v_xor_b32 v69, s29, v69
    v_xor_b32 v70, s30, v70
    v_xor_b32 v71, s85, v71
    v_xor_b32 v72, s28, v72
L_pad11:
    s_cbranch_execz L_pad12
    v_xor_b32 v73, s29, v73
    v_xor_b32 v74, s30, v74
    v_xor_b32 v75, s85, v75
    v_xor_b32 v76, s28, v76
    v_xor_b32 v77, s29, v77
    v_xor_b32 v78, s30, v78
    v_xor_b32 v79, s85, v79
    v_or3_b32 v24, v64, v65, v66
    v_or3_b32 v25, v67, v68, v69
    v_or3_b32 v24, v24, v70, v71
    v_or3_b32 v25, v25, v72, v73
    v_or3_b32 v24, v24, v74, v75
    v_or3_b32 v25, v25, v76, v77
    v_or3_b32 v24, v24, v78, v79
    v_or_b32 v25, v25, v24
    v_cmp_ne_u32_sdwa vcc, v25, v7 src0_sel:BYTE_0 src1_sel:DWORD
    v_pk_add_f32 v[64:65], v[64:65], v[68:69]
    v_pk_add_f32 v[72:73], v[72:73], v[76:77]
    v_pk_add_f32 v[66:67], v[66:67], v[70:71]
    v_pk_add_f32 v[74:75], v[74:75], v[78:79]
    s_cbranch_vccnz L_pollh_f
    v_pk_add_f32 v[28:29], v[28:29], v[64:65]
    v_pk_add_f32 v[30:31], v[30:31], v[66:67]
    v_pk_add_f32 v[28:29], v[28:29], v[72:73]
    v_pk_add_f32 v[30:31], v[30:31], v[74:75]
    s_branch L_chk1
L_pollh_f:
    s_sub_u32 s33, s33, 1
    s_cbranch_scc1 L_end
    s_cmp_gt_u32 s33, 1048567
    s_cbranch_scc1 L_pollh
    s_cmp_lg_u32 s33, 1048567
    s_cbranch_scc1 L_pollh_x
    v_bfi_b32 v35, v17, s31, v35
    global_store_dwordx4 v10, v[32:35], s[88:89] sc1
L_pollh_x:
    s_bitcmp0_b32 s33, 0
    s_cselect_b64 s[86:87], s[16:17], s[88:89]
    s_cselect_b32 s85, s84, s31
L_pollh:
    global_load_dwordx4 v[64:67], v14, s[86:87] offset:-4096 sc1
    global_load_dwordx4 v[68:71], v14, s[86:87] offset:-2048 sc1
    global_load_dwordx4 v[72:75], v14, s[86:87] offset:0 sc1
L_pad12:
    s_cbranch_execz L_pad13
    global_load_dwordx4 v[76:79], v14, s[86:87] offset:2048 sc1
    global_load_dwordx4 v[52:55], v11, s[86:87] sc1
    global_load_dwordx4 v[56:59], v12, s[86:87] sc1
    global_load_dwordx4 v[60:63], v13, s[86:87] sc1
    s_branch L_chkh
L_pad13:
L_padE:
    s_mov_b64 exec, -1
L_side:
    s_waitcnt vmcnt(0) lgkmcnt(0)
    s_load_dword s21, s[16:17], 0
    s_lshr_b32 s24, s2, 3
    s_and_b32 s66, s2, 7
    s_mul_i32 s19, s24, 37
    s_lshr_b32 s19, s19, 8
    s_mul_i32 s25, s19, 7
    s_sub_u32 s67, s24, s25
    s_add_u32 s25, s66, 3
    s_and_b32 s25, s25, 7
    s_cmp_eq_u32 s25, 7
    s_cselect_b32 s25, 0, s25
    s_cmp_eq_u32 s67, s25
    s_cselect_b32 s36, 1, 0
    s_cmp_eq_u32 s19, 4
    s_cselect_b32 s36, 2, s36
    s_cselect_b32 s19, s67, s19
    s_cselect_b32 s67, s25, s67
    s_cselect_b32 s37, 128, 0
    s_mul_i32 s18, s66, 7
    s_add_u32 s18, s18, s67
    s_mov_b32 s33, 0x100003
    s_lshr_b32 s20, s20, 6
    s_sub_u32 s23, s20, 4
    v_and_b32 v1, 63, v0
    v_mov_b32 v7, 0
    v_mov_b32 v17, 0xff
    v_mov_b32 v18, 0xc0135761
    v_bfe_u32 v24, v0, 1, 1
    v_mul_u32_u24 v8, 1168, v24
    v_bfe_u32 v24, v0, 2, 2
    v_mul_u32_u24 v24, 288, v24
    v_add_u32 v8, v24, v8
    v_bfe_u32 v26, v0, 4, 2
    v_lshl_add_u32 v8, v26, 4, v8
    v_and_b32 v25, 1, v0
    v_lshl_add_u32 v8, v25, 3, v8
    s_lshl_b32 s24, s23, 6
    v_add_u32 v8, s24, v8
    v_add_u32 v9, 128, v8
    s_lshl_b32 s24, s23, 8
    s_add_u32 s24, s24, 10240
    v_lshl_add_u32 v15, v1, 2, s24
    s_lshl_b32 s24, s23, 2
    s_add_u32 s24, s24, 10752
    v_mov_b32 v16, s24
    ds_write_b32 v16, v7
    s_lshl_b32 s25, s23, 10
    s_add_u32 s25, s25, 8192
    v_lshl_add_u32 v27, v1, 4, s25
    s_lshl_b32 s24, s18, 2
    s_lshl_b32 s25, s66, 2
    s_add_u32 s22, s25, 224
    s_cmp_eq_u32 s36, 2
    s_cselect_b32 s24, s22, s24
    s_add_u32 s24, s24, s19
    s_lshl_b32 s24, s24, 11
    v_add_u32 v10, s24, v27
    s_add_u32 s24, s19, 1
    s_and_b32 s24, s24, 3
    s_lshl2_add_u32 s24, s18, s24
    s_lshl_b32 s24, s24, 11
    v_add_u32 v11, s24, v27
    s_add_u32 s24, s19, 2
    s_and_b32 s24, s24, 3
    s_lshl2_add_u32 s24, s18, s24
    s_lshl_b32 s24, s24, 11
    v_add_u32 v12, s24, v27
    s_add_u32 s24, s19, 3
    s_and_b32 s24, s24, 3
    s_lshl2_add_u32 s24, s18, s24
    s_lshl_b32 s24, s24, 11
    v_add_u32 v13, s24, v27
    s_lshl_b32 s24, s22, 11
    s_add_u32 s24, s24, 4096
    v_add_u32 v14, s24, v27
    s_mov_b64 s[86:87], s[16:17]
    s_add_u32 s88, s16, 1048576
    s_addc_u32 s89, s17, 0
    global_load_dword v52, v10, s[16:17]
    s_lshl_b32 s24, s66, 12
    s_add_u32 s24, s24, 589824
    v_lshl_add_u32 v21, v1, 7, s24
    s_mov_b32 s34, 32
    s_mov_b64 exec, 0xfffffff
    global_load_dword v53, v21, s[16:17] sc1
    s_mov_b64 exec, -1
    s_bfe_u32 s18, s2, 0x40003
    s_lshl4_add_u32 s18, s66, s18
    s_lshr_b32 s19, s2, 7
    s_lshl1_add_u32 s19, s19, s23
    s_or_b32 s35, s2, s23
    v_lshrrev_b32 v24, 1, v1
    v_lshlrev_b32 v19, 7, v24
    v_lshl_add_u32 v19, v25, 4, v19
    s_mul_i32 s24, s18, 7168
    s_lshl_b32 s25, s19, 5
    s_add_u32 s24, s24, s25
    s_add_u32 s24, s24, 2293760
    v_add_u32 v19, s24, v19
    s_lshr_b32 s24, s18, 5
    s_lshl_b32 s24, s24, 9
    s_bfe_u32 s25, s18, 0x20003
    s_lshl_b32 s25, s25, 11
    s_add_u32 s24, s24, s25
    s_and_b32 s25, s18, 7
    s_lshl_b32 s25, s25, 6
    s_add_u32 s24, s24, s25
    s_lshl4_add_u32 s24, s19, s24
    v_lshlrev_b32 v20, 3, v25
    v_lshl_add_u32 v20, v26, 1, v20
    v_add_u32 v20, s24, v20
    v_mov_b32 v80, 0
    v_mov_b32 v81, 0
    v_mov_b32 v82, 0
    v_mov_b32 v83, 0
    s_mov_b32 s70, -1
    s_mov_b32 s71, 0xffffff
    s_mov_b32 s72, -1
    s_mov_b32 s73, 0xffffff
    s_mov_b32 s26, 0x00030003
    s_mov_b32 s27, 0x00030003
    s_getreg_b32 s84, hwreg(HW_REG_XCC_ID, 0, 4)
    s_waitcnt lgkmcnt(0)
    s_add_u32 s21, s21, 0x9f3b79b1
    s_bfe_u32 s28, s21, 0x80000
    s_bfe_u32 s29, s21, 0x80008
    s_bfe_u32 s30, s21, 0x80010
    s_bfe_u32 s31, s21, 0x80018
    v_mov_b32 v22, s21
    s_mov_b32 s32, 0xbdd2d3e8
    s_add_u32 s84, s84, 1
    s_xor_b32 s84, s84, s31
    s_mov_b32 s85, s84
    s_barrier
    s_branch L_side1
L_fin:
L_end:
    s_endpgm
.fill 248, 4, 0xbf810000
.section .rodata,"a"
.p2align 6
.amdhsa_kernel standalone__geglu_ffn__decode_kernel
  .amdhsa_next_free_vgpr 168
  .amdhsa_next_free_sgpr 90
  .amdhsa_accum_offset 168
  .amdhsa_group_segment_fixed_size 0
  .amdhsa_kernarg_size 56
  .amdhsa_user_sgpr_count 2
  .amdhsa_user_sgpr_kernarg_segment_ptr 1
  .amdhsa_system_sgpr_workgroup_id_x 1
  .amdhsa_float_denorm_mode_32 3
.end_amdhsa_kernel
```
